```python
import torch

def _softmax(x, axis=-1):
    return torch.softmax(x, dim=axis)
def _gelu(x):
    return torch.nn.functional.gelu(x, approximate="tanh")
def _silu(x):
    return torch.nn.functional.silu(x)
def _sigmoid(x):
    return torch.sigmoid(x)
def _layernorm(x, axis=-1, eps=1e-5):
    m = x.mean(dim=axis, keepdim=True)
    v = x.var(dim=axis, keepdim=True, unbiased=False)
    return (x - m) / torch.sqrt(v + eps)
def _scatter_add(tgt, idx, src, axis=0):
    return tgt.clone().index_add_(axis, idx, src)
def _segment_sum(src, seg, n):
    out = torch.zeros((n,) + src.shape[1:], dtype=src.dtype)
    return out.index_add_(0, seg, src)
def _pad(x, pw):
    flat = tuple(v for pair in reversed(pw) for v in pair)
    return torch.nn.functional.pad(x, flat)

kernel_name = 'standalone__gqa_softmax__decode'

def setup_inputs():

    _w = (lambda a: (lambda t: t.to(torch.bfloat16) if t.is_floating_point() else t)(torch.as_tensor(a)))
    B, Hq, Hkv, Sq, Sk, D = 2, 32, 32, 1, 4096, 128
    return {
        "q": _w((lambda *s: torch.randn(*s, dtype=torch.bfloat16) * 0.8)(B, Hq, Sq, D)),
        "k": _w((lambda *s: torch.randn(*s, dtype=torch.bfloat16) * 0.8)(B, Hkv, Sk, D)),
        "v": _w((lambda *s: torch.randn(*s, dtype=torch.bfloat16) * 0.05)(B, Hkv, Sk, D)),
    }

def reference(q, k, v):
    B, Hq, Sq, D = q.shape
    Hkv = k.shape[1]
    rep = Hq // Hkv
    k = (lambda x, n, axis: torch.repeat_interleave(x, n, dim=axis))(k, rep, axis=1)
    v = (lambda x, n, axis: torch.repeat_interleave(x, n, dim=axis))(v, rep, axis=1)
    scale = D ** -0.5
    scores = torch.einsum("bhqd,bhkd->bhqk", q, k) * scale
    p = _softmax(scores, axis=-1)
    return torch.einsum("bhqk,bhkd->bhqd", p, v)
```

```asm
; @launch grid=(256,1,1) block=(320,1,1) lds=2112
.amdgcn_target "amdgcn-amd-amdhsa--gfx950"
.text
.globl standalone__gqa_softmax__decode_kernel
.p2align 8
.type standalone__gqa_softmax__decode_kernel,@function
standalone__gqa_softmax__decode_kernel:
    s_cmp_ge_u32 s2, 256
    s_cbranch_scc1 L_end
    s_load_dwordx4 s[4:7], s[0:1], 0
    s_load_dwordx4 s[8:11], s[0:1], 16
    s_load_dwordx4 s[12:15], s[0:1], 32
    v_lshrrev_b32 v36, 6, v0
    v_and_b32 v37, 63, v0
    v_readfirstlane_b32 s24, v36
    v_lshlrev_b32 v1, 4, v37
    v_lshlrev_b32 v36, 12, v36
    s_lshr_b32 s25, s2, 5
    s_lshl_b32 s25, s25, 3
    s_and_b32 s27, s2, 7
    s_or_b32 s25, s25, s27
    s_bfe_u32 s35, s2, 0x20003
    s_lshl_b32 s27, s35, 14
    v_add3_u32 v1, v1, v36, s27
    s_lshl_b32 s26, s25, 8
    v_and_b32 v37, 15, v0
    v_lshlrev_b32 v37, 4, v37
    v_add_u32 v37, s26, v37
    v_add_u32 v2, 65536, v1
    v_add_u32 v3, 131072, v1
    s_lshl_b32 s27, s25, 20
    s_mov_b32 s18, 0x100000
    s_mov_b32 s19, 0x20000
    s_mov_b32 s22, 0x100000
    s_mov_b32 s23, 0x20000
    s_mov_b32 s29, 0
    s_cmp_eq_u32 s24, 4
    s_waitcnt lgkmcnt(0)
    s_cbranch_scc1 L_helper
    s_add_u32 s16, s6, s27
    s_addc_u32 s17, s7, 0
    global_load_dwordx4 v[4:7], v37, s[4:5]
    buffer_load_dwordx4 v[56:59], v1, s[16:19], 0 offen offset:0 nt
    buffer_load_dwordx4 v[60:63], v1, s[16:19], 0 offen offset:1024 nt
    buffer_load_dwordx4 v[64:67], v1, s[16:19], 0 offen offset:2048 nt
    buffer_load_dwordx4 v[68:71], v1, s[16:19], 0 offen offset:3072 nt
    buffer_load_dwordx4 v[40:43], v2, s[16:19], 0 offen offset:0 nt
    s_add_u32 s20, s8, s27
    s_addc_u32 s21, s9, 0
    s_mov_b32 s28, 0x3e0293ee
    v_and_b32 v36, 15, v0
    v_and_b32 v12, 1, v36
    v_mov_b32 v13, 0xffff
    v_lshlrev_b32 v12, 4, v12
    v_lshlrev_b32 v12, v12, v13
    v_lshrrev_b32 v13, 1, v36
    v_cmp_eq_u32 vcc, 0, v13
    v_mov_b32 v32, 0
    s_nop 0
    v_cndmask_b32 v20, 0, v12, vcc
    v_cmp_eq_u32 vcc, 1, v13
    v_mov_b32 v33, 0
    s_nop 0
    v_cndmask_b32 v21, 0, v12, vcc
    v_cmp_eq_u32 vcc, 2, v13
    v_mov_b32 v34, 0
    s_nop 0
    v_cndmask_b32 v22, 0, v12, vcc
    v_cmp_eq_u32 vcc, 3, v13
    v_mov_b32 v35, 0
    s_nop 0
    v_cndmask_b32 v23, 0, v12, vcc
    s_waitcnt vmcnt(4)
    buffer_load_dwordx4 v[44:47], v2, s[16:19], 0 offen offset:1024 nt
    v_dot2_f32_bf16 v8, v56, v4, 0
    v_dot2_f32_bf16 v8, v57, v5, v8
    v_dot2_f32_bf16 v8, v58, v6, v8
    v_dot2_f32_bf16 v8, v59, v7, v8
    s_waitcnt vmcnt(4)
    buffer_load_dwordx4 v[48:51], v2, s[16:19], 0 offen offset:2048 nt
    v_dot2_f32_bf16 v9, v60, v4, 0
    v_dot2_f32_bf16 v9, v61, v5, v9
    v_dot2_f32_bf16 v9, v62, v6, v9
    v_dot2_f32_bf16 v9, v63, v7, v9
    s_waitcnt vmcnt(4)
    buffer_load_dwordx4 v[52:55], v2, s[16:19], 0 offen offset:3072 nt
    v_dot2_f32_bf16 v10, v64, v4, 0
    v_dot2_f32_bf16 v10, v65, v5, v10
    v_dot2_f32_bf16 v10, v66, v6, v10
    v_dot2_f32_bf16 v10, v67, v7, v10
    s_waitcnt vmcnt(4)
    buffer_load_dwordx4 v[56:59], v1, s[20:23], 0 offen offset:0 nt
    v_dot2_f32_bf16 v11, v68, v4, 0
    v_dot2_f32_bf16 v11, v69, v5, v11
    v_dot2_f32_bf16 v11, v70, v6, v11
    v_dot2_f32_bf16 v11, v71, v7, v11
    s_nop 2
    v_add_f32_dpp v12, v8, v8 row_ror:8 row_mask:0xf bank_mask:0x3
    v_add_f32_dpp v13, v10, v10 row_ror:8 row_mask:0xf bank_mask:0x3
    v_add_f32_dpp v12, v9, v9 row_ror:8 row_mask:0xf bank_mask:0xc
    v_add_f32_dpp v13, v11, v11 row_ror:8 row_mask:0xf bank_mask:0xc
    s_nop 0
    v_add_f32_dpp v14, v12, v12 row_half_mirror row_mask:0xf bank_mask:0x5
    v_add_f32_dpp v14, v13, v13 row_half_mirror row_mask:0xf bank_mask:0xa
    s_nop 1
    v_add_f32_dpp v14, v14, v14 quad_perm:[1,0,3,2] row_mask:0xf bank_mask:0xf
    s_nop 1
    v_add_f32_dpp v15, v14, v14 quad_perm:[2,3,0,1] row_mask:0xf bank_mask:0xf
    s_nop 1
    v_max_f32_dpp v16, v15, v15 row_ror:4 row_mask:0xf bank_mask:0xf
    s_nop 1
    v_max_f32_dpp v16, v16, v16 row_ror:8 row_mask:0xf bank_mask:0xf
    s_nop 0
    v_mov_b32 v37, v16
    s_nop 1
    v_permlane16_swap_b32 v16, v37
    v_max_f32 v16, v16, v37
    s_nop 0
    v_mov_b32 v37, v16
    s_nop 1
    v_permlane32_swap_b32 v16, v37
    v_max_f32 v16, v16, v37
    v_mul_f32 v17, s28, v16
    v_mov_b32 v18, 0
    v_fma_f32 v38, v15, s28, -v17
    v_exp_f32 v38, v38
    s_nop 0
    v_add_f32 v18, v18, v38
    v_cvt_pk_bf16_f32 v19, v38, v38
L_loop:
    s_waitcnt vmcnt(4)
    buffer_load_dwordx4 v[60:63], v1, s[20:23], s29 offen offset:1024 nt
    v_dot2_f32_bf16 v8, v40, v4, 0
    v_dot2_f32_bf16 v8, v41, v5, v8
    v_dot2_f32_bf16 v8, v42, v6, v8
    v_dot2_f32_bf16 v8, v43, v7, v8
    s_waitcnt vmcnt(4)
    buffer_load_dwordx4 v[64:67], v1, s[20:23], s29 offen offset:2048 nt
    v_dot2_f32_bf16 v9, v44, v4, 0
    v_dot2_f32_bf16 v9, v45, v5, v9
    v_dot2_f32_bf16 v9, v46, v6, v9
    v_dot2_f32_bf16 v9, v47, v7, v9
    s_waitcnt vmcnt(4)
    buffer_load_dwordx4 v[68:71], v1, s[20:23], s29 offen offset:3072 nt
    v_dot2_f32_bf16 v10, v48, v4, 0
    v_dot2_f32_bf16 v10, v49, v5, v10
    v_dot2_f32_bf16 v10, v50, v6, v10
    v_dot2_f32_bf16 v10, v51, v7, v10
    s_waitcnt vmcnt(4)
    buffer_load_dwordx4 v[40:43], v3, s[16:19], s29 offen offset:0 nt
    v_dot2_f32_bf16 v11, v52, v4, 0
    v_dot2_f32_bf16 v11, v53, v5, v11
    v_dot2_f32_bf16 v11, v54, v6, v11
    v_dot2_f32_bf16 v11, v55, v7, v11
    s_nop 2
    v_add_f32_dpp v12, v8, v8 row_ror:8 row_mask:0xf bank_mask:0x3
    v_add_f32_dpp v13, v10, v10 row_ror:8 row_mask:0xf bank_mask:0x3
    v_add_f32_dpp v12, v9, v9 row_ror:8 row_mask:0xf bank_mask:0xc
    v_add_f32_dpp v13, v11, v11 row_ror:8 row_mask:0xf bank_mask:0xc
    s_nop 0
    v_add_f32_dpp v14, v12, v12 row_half_mirror row_mask:0xf bank_mask:0x5
    v_add_f32_dpp v14, v13, v13 row_half_mirror row_mask:0xf bank_mask:0xa
    s_nop 1
    v_add_f32_dpp v14, v14, v14 quad_perm:[1,0,3,2] row_mask:0xf bank_mask:0xf
    s_nop 1
    v_add_f32_dpp v15, v14, v14 quad_perm:[2,3,0,1] row_mask:0xf bank_mask:0xf
    v_and_b32_dpp v24, v19, v20 row_newbcast:0 row_mask:0xf bank_mask:0xf
    v_and_b32_dpp v25, v19, v21 row_newbcast:0 row_mask:0xf bank_mask:0xf
    v_and_b32_dpp v26, v19, v22 row_newbcast:0 row_mask:0xf bank_mask:0xf
    v_and_b32_dpp v27, v19, v23 row_newbcast:0 row_mask:0xf bank_mask:0xf
    s_waitcnt vmcnt(4)
    buffer_load_dwordx4 v[44:47], v3, s[16:19], s29 offen offset:1024 nt
    v_mfma_f32_16x16x32_bf16 v[32:35], v[24:27], v[56:59], v[32:35]
    v_and_b32_dpp v28, v19, v20 row_newbcast:8 row_mask:0xf bank_mask:0xf
    v_and_b32_dpp v29, v19, v21 row_newbcast:8 row_mask:0xf bank_mask:0xf
    v_and_b32_dpp v30, v19, v22 row_newbcast:8 row_mask:0xf bank_mask:0xf
    v_and_b32_dpp v31, v19, v23 row_newbcast:8 row_mask:0xf bank_mask:0xf
    s_waitcnt vmcnt(4)
    buffer_load_dwordx4 v[48:51], v3, s[16:19], s29 offen offset:2048 nt
    v_mfma_f32_16x16x32_bf16 v[32:35], v[28:31], v[60:63], v[32:35]
    v_and_b32_dpp v24, v19, v20 row_newbcast:4 row_mask:0xf bank_mask:0xf
    v_and_b32_dpp v25, v19, v21 row_newbcast:4 row_mask:0xf bank_mask:0xf
    v_and_b32_dpp v26, v19, v22 row_newbcast:4 row_mask:0xf bank_mask:0xf
    v_and_b32_dpp v27, v19, v23 row_newbcast:4 row_mask:0xf bank_mask:0xf
    s_waitcnt vmcnt(4)
    buffer_load_dwordx4 v[52:55], v3, s[16:19], s29 offen offset:3072 nt
    v_mfma_f32_16x16x32_bf16 v[32:35], v[24:27], v[64:67], v[32:35]
    v_and_b32_dpp v28, v19, v20 row_newbcast:12 row_mask:0xf bank_mask:0xf
    v_and_b32_dpp v29, v19, v21 row_newbcast:12 row_mask:0xf bank_mask:0xf
    v_and_b32_dpp v30, v19, v22 row_newbcast:12 row_mask:0xf bank_mask:0xf
    v_and_b32_dpp v31, v19, v23 row_newbcast:12 row_mask:0xf bank_mask:0xf
    s_waitcnt vmcnt(4)
    buffer_load_dwordx4 v[56:59], v2, s[20:23], s29 offen offset:0 nt
    v_mfma_f32_16x16x32_bf16 v[32:35], v[28:31], v[68:71], v[32:35]
    v_cmp_gt_f32 vcc, v15, v16
    s_add_u32 s29, s29, 65536
    s_cbranch_vccz L_nomax
    s_nop 1
    v_max_f32_dpp v36, v15, v15 row_ror:4 row_mask:0xf bank_mask:0xf
    s_nop 1
    v_max_f32_dpp v36, v36, v36 row_ror:8 row_mask:0xf bank_mask:0xf
    s_nop 0
    v_mov_b32 v37, v36
    s_nop 1
    v_permlane16_swap_b32 v36, v37
    v_max_f32 v36, v36, v37
    s_nop 0
    v_mov_b32 v37, v36
    s_nop 1
    v_permlane32_swap_b32 v36, v37
    v_max_f32 v36, v36, v37
    v_max_f32 v36, v36, v16
    v_sub_f32 v39, v16, v36
    v_mul_f32 v39, s28, v39
    v_exp_f32 v39, v39
    v_mov_b32 v16, v36
    v_mul_f32 v17, s28, v36
    v_mul_f32 v18, v18, v39
    v_mul_f32 v32, v32, v39
    v_mul_f32 v33, v33, v39
    v_mul_f32 v34, v34, v39
    v_mul_f32 v35, v35, v39
L_nomax:
    v_fma_f32 v38, v15, s28, -v17
    v_exp_f32 v38, v38
    s_nop 0
    v_add_f32 v18, v18, v38
    v_cvt_pk_bf16_f32 v19, v38, v38
    s_cmp_lt_u32 s29, 917504
    s_cbranch_scc1 L_loop
    s_barrier
    s_waitcnt vmcnt(4)
    buffer_load_dwordx4 v[60:63], v1, s[20:23], s29 offen offset:1024 nt
    v_dot2_f32_bf16 v8, v40, v4, 0
    v_dot2_f32_bf16 v8, v41, v5, v8
    v_dot2_f32_bf16 v8, v42, v6, v8
    v_dot2_f32_bf16 v8, v43, v7, v8
    s_waitcnt vmcnt(4)
    buffer_load_dwordx4 v[64:67], v1, s[20:23], s29 offen offset:2048 nt
    v_dot2_f32_bf16 v9, v44, v4, 0
    v_dot2_f32_bf16 v9, v45, v5, v9
    v_dot2_f32_bf16 v9, v46, v6, v9
    v_dot2_f32_bf16 v9, v47, v7, v9
    s_waitcnt vmcnt(4)
    buffer_load_dwordx4 v[68:71], v1, s[20:23], s29 offen offset:3072 nt
    v_dot2_f32_bf16 v10, v48, v4, 0
    v_dot2_f32_bf16 v10, v49, v5, v10
    v_dot2_f32_bf16 v10, v50, v6, v10
    v_dot2_f32_bf16 v10, v51, v7, v10
    s_waitcnt vmcnt(4)
    buffer_load_dwordx4 v[40:43], v2, s[20:23], s29 offen offset:0 nt
    v_dot2_f32_bf16 v11, v52, v4, 0
    v_dot2_f32_bf16 v11, v53, v5, v11
    v_dot2_f32_bf16 v11, v54, v6, v11
    v_dot2_f32_bf16 v11, v55, v7, v11
    s_nop 2
    v_add_f32_dpp v12, v8, v8 row_ror:8 row_mask:0xf bank_mask:0x3
    v_add_f32_dpp v13, v10, v10 row_ror:8 row_mask:0xf bank_mask:0x3
    v_add_f32_dpp v12, v9, v9 row_ror:8 row_mask:0xf bank_mask:0xc
    v_add_f32_dpp v13, v11, v11 row_ror:8 row_mask:0xf bank_mask:0xc
    s_nop 0
    v_add_f32_dpp v14, v12, v12 row_half_mirror row_mask:0xf bank_mask:0x5
    v_add_f32_dpp v14, v13, v13 row_half_mirror row_mask:0xf bank_mask:0xa
    s_nop 1
    v_add_f32_dpp v14, v14, v14 quad_perm:[1,0,3,2] row_mask:0xf bank_mask:0xf
    s_nop 1
    v_add_f32_dpp v15, v14, v14 quad_perm:[2,3,0,1] row_mask:0xf bank_mask:0xf
    v_and_b32_dpp v24, v19, v20 row_newbcast:0 row_mask:0xf bank_mask:0xf
    v_and_b32_dpp v25, v19, v21 row_newbcast:0 row_mask:0xf bank_mask:0xf
    v_and_b32_dpp v26, v19, v22 row_newbcast:0 row_mask:0xf bank_mask:0xf
    v_and_b32_dpp v27, v19, v23 row_newbcast:0 row_mask:0xf bank_mask:0xf
    s_waitcnt vmcnt(4)
    buffer_load_dwordx4 v[44:47], v2, s[20:23], s29 offen offset:1024 nt
    v_mfma_f32_16x16x32_bf16 v[32:35], v[24:27], v[56:59], v[32:35]
    v_and_b32_dpp v28, v19, v20 row_newbcast:8 row_mask:0xf bank_mask:0xf
    v_and_b32_dpp v29, v19, v21 row_newbcast:8 row_mask:0xf bank_mask:0xf
    v_and_b32_dpp v30, v19, v22 row_newbcast:8 row_mask:0xf bank_mask:0xf
    v_and_b32_dpp v31, v19, v23 row_newbcast:8 row_mask:0xf bank_mask:0xf
    s_waitcnt vmcnt(4)
    buffer_load_dwordx4 v[48:51], v2, s[20:23], s29 offen offset:2048 nt
    v_mfma_f32_16x16x32_bf16 v[32:35], v[28:31], v[60:63], v[32:35]
    v_and_b32_dpp v24, v19, v20 row_newbcast:4 row_mask:0xf bank_mask:0xf
    v_and_b32_dpp v25, v19, v21 row_newbcast:4 row_mask:0xf bank_mask:0xf
    v_and_b32_dpp v26, v19, v22 row_newbcast:4 row_mask:0xf bank_mask:0xf
    v_and_b32_dpp v27, v19, v23 row_newbcast:4 row_mask:0xf bank_mask:0xf
    s_waitcnt vmcnt(4)
    buffer_load_dwordx4 v[52:55], v2, s[20:23], s29 offen offset:3072 nt
    v_mfma_f32_16x16x32_bf16 v[32:35], v[24:27], v[64:67], v[32:35]
    v_and_b32_dpp v28, v19, v20 row_newbcast:12 row_mask:0xf bank_mask:0xf
    v_and_b32_dpp v29, v19, v21 row_newbcast:12 row_mask:0xf bank_mask:0xf
    v_and_b32_dpp v30, v19, v22 row_newbcast:12 row_mask:0xf bank_mask:0xf
    v_and_b32_dpp v31, v19, v23 row_newbcast:12 row_mask:0xf bank_mask:0xf
    s_waitcnt vmcnt(4)
    s_nop 0
    v_mfma_f32_16x16x32_bf16 v[32:35], v[28:31], v[68:71], v[32:35]
    s_nop 1
    v_max_f32_dpp v36, v15, v15 row_ror:4 row_mask:0xf bank_mask:0xf
    s_nop 1
    v_max_f32_dpp v36, v36, v36 row_ror:8 row_mask:0xf bank_mask:0xf
    s_nop 0
    v_mov_b32 v37, v36
    s_nop 1
    v_permlane16_swap_b32 v36, v37
    v_max_f32 v36, v36, v37
    s_nop 0
    v_mov_b32 v37, v36
    s_nop 1
    v_permlane32_swap_b32 v36, v37
    v_max_f32 v36, v36, v37
    v_max_f32 v36, v36, v16
    s_lshl_b32 s27, s24, 2
    v_mov_b32 v37, s27
    ds_write_b32 v37, v36 offset:0
    v_mov_b32 v38, 0
    s_waitcnt lgkmcnt(0)
    s_barrier
    ds_read_b128 v[72:75], v38 offset:0
    s_waitcnt lgkmcnt(0)
    v_max3_f32 v36, v72, v73, v74
    v_max_f32 v36, v36, v75
    v_sub_f32 v39, v16, v36
    v_mul_f32 v39, s28, v39
    v_exp_f32 v39, v39
    v_mov_b32 v16, v36
    v_mul_f32 v17, s28, v36
    v_mul_f32 v18, v18, v39
    v_mul_f32 v32, v32, v39
    v_mul_f32 v33, v33, v39
    v_mul_f32 v34, v34, v39
    v_mul_f32 v35, v35, v39
    v_fma_f32 v38, v15, s28, -v17
    v_exp_f32 v38, v38
    s_nop 0
    v_add_f32 v18, v18, v38
    v_cvt_pk_bf16_f32 v19, v38, v38
    s_nop 1
    v_add_f32_dpp v36, v18, v18 row_ror:4 row_mask:0xf bank_mask:0xf
    s_nop 1
    v_add_f32_dpp v36, v36, v36 row_ror:8 row_mask:0xf bank_mask:0xf
    s_nop 0
    v_mov_b32 v37, v36
    s_nop 1
    v_permlane16_swap_b32 v36, v37
    v_add_f32 v36, v36, v37
    s_nop 0
    v_mov_b32 v37, v36
    s_nop 1
    v_permlane32_swap_b32 v36, v37
    v_add_f32 v36, v36, v37
    v_mov_b32 v37, s27
    ds_write_b32 v37, v36 offset:16
    v_and_b32 v38, 63, v0
    v_lshlrev_b32 v38, 4, v38
    s_lshl_b32 s27, s24, 9
    v_add_u32 v39, s27, v38
    v_and_b32_dpp v24, v19, v20 row_newbcast:0 row_mask:0xf bank_mask:0xf
    v_and_b32_dpp v25, v19, v21 row_newbcast:0 row_mask:0xf bank_mask:0xf
    v_and_b32_dpp v26, v19, v22 row_newbcast:0 row_mask:0xf bank_mask:0xf
    v_and_b32_dpp v27, v19, v23 row_newbcast:0 row_mask:0xf bank_mask:0xf
    s_waitcnt vmcnt(3)
    s_nop 0
    v_mfma_f32_16x16x32_bf16 v[32:35], v[24:27], v[40:43], v[32:35]
    v_and_b32_dpp v28, v19, v20 row_newbcast:8 row_mask:0xf bank_mask:0xf
    v_and_b32_dpp v29, v19, v21 row_newbcast:8 row_mask:0xf bank_mask:0xf
    v_and_b32_dpp v30, v19, v22 row_newbcast:8 row_mask:0xf bank_mask:0xf
    v_and_b32_dpp v31, v19, v23 row_newbcast:8 row_mask:0xf bank_mask:0xf
    s_waitcnt vmcnt(2)
    s_nop 0
    v_mfma_f32_16x16x32_bf16 v[32:35], v[28:31], v[44:47], v[32:35]
    v_and_b32_dpp v24, v19, v20 row_newbcast:4 row_mask:0xf bank_mask:0xf
    v_and_b32_dpp v25, v19, v21 row_newbcast:4 row_mask:0xf bank_mask:0xf
    v_and_b32_dpp v26, v19, v22 row_newbcast:4 row_mask:0xf bank_mask:0xf
    v_and_b32_dpp v27, v19, v23 row_newbcast:4 row_mask:0xf bank_mask:0xf
    s_waitcnt vmcnt(1)
    s_nop 0
    v_mfma_f32_16x16x32_bf16 v[32:35], v[24:27], v[48:51], v[32:35]
    v_and_b32_dpp v28, v19, v20 row_newbcast:12 row_mask:0xf bank_mask:0xf
    v_and_b32_dpp v29, v19, v21 row_newbcast:12 row_mask:0xf bank_mask:0xf
    v_and_b32_dpp v30, v19, v22 row_newbcast:12 row_mask:0xf bank_mask:0xf
    v_and_b32_dpp v31, v19, v23 row_newbcast:12 row_mask:0xf bank_mask:0xf
    s_waitcnt vmcnt(0)
    s_nop 0
    v_mfma_f32_16x16x32_bf16 v[32:35], v[28:31], v[52:55], v[32:35]
    s_mov_b32 exec_hi, 0
    s_nop 7
    ds_write_b128 v39, v[32:35] offset:64
    s_waitcnt lgkmcnt(0)
    s_barrier
    s_endpgm
L_helper:
    v_and_b32 v8, 63, v0
    v_lshlrev_b32 v8, 4, v8
    s_lshl_b32 s36, s25, 2
    s_or_b32 s36, s36, s35
    s_xor_b32 s32, s36, 1
    s_lshl_b32 s32, s32, 10
    s_xor_b32 s33, s36, 2
    s_lshl_b32 s33, s33, 10
    s_xor_b32 s34, s36, 3
    s_lshl_b32 s34, s34, 10
    s_lshl_b32 s36, s36, 10
    v_add_u32 v9, s36, v8
    v_mov_b32 v56, -1
    v_mov_b32 v57, -1
    v_mov_b32 v58, -1
    v_mov_b32 v59, -1
    s_mov_b32 exec_hi, 1
    global_store_dwordx4 v9, v[56:59], s[14:15] sc1
    s_lshl_b32 s27, s25, 2
    v_mov_b32 v10, s27
    s_getreg_b32 s27, hwreg(HW_REG_XCC_ID, 0, 4)
    s_lshl_b32 s31, s35, 2
    s_add_u32 s31, s31, 8
    s_lshl_b32 s27, s27, s31
    s_or_b32 s27, s27, 1
    v_mov_b32 v11, s27
    s_mov_b32 s28, 0x3e0293ee
    s_mov_b32 exec_hi, -1
    v_lshrrev_b32 v6, 8, v8
    v_and_b32 v9, 0xf0, v8
    v_lshlrev_b32 v6, 3, v6
    v_add3_u32 v6, v6, v9, s26
    s_mov_b32 exec_hi, 0
    s_mov_b32 exec_lo, 1
    s_mov_b32 s30, 0
    s_mov_b32 s37, 0
    s_waitcnt vmcnt(0)
    global_atomic_add v10, v11, s[12:13]
    s_barrier
    global_load_dword v11, v10, s[12:13] sc1
    s_waitcnt vmcnt(0)
    v_readfirstlane_b32 s27, v11
    s_and_b32 s31, s27, 0xff
    s_cmp_lg_u32 s31, 4
    s_cbranch_scc1 L_flags_done
    s_mov_b32 s30, 1
    s_lshr_b32 s27, s27, 8
    s_and_b32 s31, s27, 0xf
    s_mul_i32 s31, s31, 0x1111
    s_cmp_lg_u32 s31, s27
    s_cbranch_scc1 L_flags_done
    s_mov_b32 s37, 1
L_flags_done:
    s_mov_b32 exec_lo, -1
    v_add_u32 v3, s32, v8
    v_mov_b32 v57, s32
    v_add_u32 v4, s33, v8
    v_mov_b32 v58, s33
    v_add_u32 v5, s34, v8
    v_mov_b32 v59, s34
    v_mov_b32 v9, 0
    s_barrier
    s_cmp_eq_u32 s30, 0
    s_cbranch_scc1 L_no_a0_loads
    global_load_dwordx4 v[12:15], v3, s[14:15] sc1
    global_load_dwordx2 v[16:17], v57, s[14:15] offset:512 sc1
    global_load_dwordx4 v[20:23], v4, s[14:15] sc1
    global_load_dwordx2 v[24:25], v58, s[14:15] offset:512 sc1
    global_load_dwordx4 v[28:31], v5, s[14:15] sc1
    global_load_dwordx2 v[32:33], v59, s[14:15] offset:512 sc1
L_no_a0_loads:
    ds_read_b128 v[64:67], v9 offset:0
    s_waitcnt lgkmcnt(0)
    v_max3_f32 v64, v64, v65, v66
    v_max_f32 v64, v64, v67
    v_mul_f32 v40, s28, v64
    s_mov_b32 s31, 0
    s_cmp_eq_u32 s30, 0
    s_cbranch_scc1 L_a0_done
    s_waitcnt vmcnt(0)
    v_max3_u32 v60, v12, v13, v14
    v_max3_u32 v61, v20, v21, v22
    v_max3_u32 v62, v28, v29, v30
    v_max3_u32 v60, v60, v15, v16
    v_max3_u32 v61, v61, v23, v24
    v_max3_u32 v62, v62, v31, v32
    v_max3_u32 v60, v60, v17, v25
    v_max3_u32 v61, v61, v62, v33
    v_max_u32 v60, v60, v61
    v_cmp_eq_u32 vcc, -1, v60
    s_cbranch_vccnz L_a0_done
    v_max3_f32 v60, v40, v16, v24
    v_max_f32 v60, v60, v32
    v_sub_f32 v52, v40, v60
    v_sub_f32 v61, v16, v60
    v_sub_f32 v62, v24, v60
    v_sub_f32 v63, v32, v60
    v_exp_f32 v52, v52
    v_exp_f32 v61, v61
    v_exp_f32 v62, v62
    v_exp_f32 v63, v63
    s_nop 0
    v_pk_mul_f32 v[44:45], v[12:13], v[60:61] op_sel:[0,1] op_sel_hi:[1,1]
    v_pk_mul_f32 v[46:47], v[14:15], v[60:61] op_sel:[0,1] op_sel_hi:[1,1]
    v_pk_mul_f32 v[48:49], v[20:21], v[62:63] op_sel:[0,0] op_sel_hi:[1,0]
    v_pk_mul_f32 v[50:51], v[22:23], v[62:63] op_sel:[0,0] op_sel_hi:[1,0]
    v_pk_mul_f32 v[28:29], v[28:29], v[62:63] op_sel:[0,1] op_sel_hi:[1,1]
    v_pk_mul_f32 v[30:31], v[30:31], v[62:63] op_sel:[0,1] op_sel_hi:[1,1]
    v_mul_f32 v53, v61, v17
    v_mul_f32 v54, v62, v25
    v_mul_f32 v63, v63, v33
    v_pk_add_f32 v[48:49], v[48:49], v[28:29]
    v_pk_add_f32 v[50:51], v[50:51], v[30:31]
    v_add_f32 v54, v54, v63
    s_mov_b32 s31, 1
L_a0_done:
    s_barrier
    ds_read_b128 v[64:67], v8 offset:64
    ds_read_b128 v[68:71], v8 offset:576
    ds_read_b128 v[72:75], v8 offset:1088
    ds_read_b128 v[76:79], v8 offset:1600
    ds_read_b128 v[80:83], v9 offset:16
    s_waitcnt lgkmcnt(3)
    v_pk_add_f32 v[64:65], v[64:65], v[68:69]
    v_pk_add_f32 v[66:67], v[66:67], v[70:71]
    s_waitcnt lgkmcnt(1)
    v_pk_add_f32 v[72:73], v[72:73], v[76:77]
    v_pk_add_f32 v[74:75], v[74:75], v[78:79]
    s_waitcnt lgkmcnt(0)
    v_add_f32 v80, v80, v81
    v_add_f32 v82, v82, v83
    v_pk_add_f32 v[36:37], v[64:65], v[72:73]
    v_pk_add_f32 v[38:39], v[66:67], v[74:75]
    v_add_f32 v41, v80, v82
    s_cmp_eq_u32 s31, 1
    s_cbranch_scc1 L_final
    v_min_u32 v36, 0xfffffffe, v36
    v_min_u32 v37, 0xfffffffe, v37
    v_min_u32 v38, 0xfffffffe, v38
    v_min_u32 v39, 0xfffffffe, v39
    v_min_u32 v40, 0xfffffffe, v40
    v_min_u32 v41, 0xfffffffe, v41
    v_add_u32 v10, s36, v8
    v_mov_b32 v11, s36
    s_cmp_eq_u32 s37, 1
    s_cbranch_scc1 L_pub_local
    global_store_dwordx4 v10, v[36:39], s[14:15] sc1
    global_store_dwordx2 v11, v[40:41], s[14:15] offset:512 sc1
    s_branch L_pub_done
L_pub_local:
    global_store_dwordx4 v10, v[36:39], s[14:15]
    global_store_dwordx2 v11, v[40:41], s[14:15] offset:512
L_pub_done:
    s_mov_b32 s31, 2
    s_cmp_eq_u32 s30, 1
    s_cbranch_scc1 L_try
    s_lshl_b32 s27, s25, 2
    v_mov_b32 v10, s27
    s_waitcnt vmcnt(0)
    global_load_dword v11, v10, s[12:13] sc1
    s_waitcnt vmcnt(0)
    v_readfirstlane_b32 s27, v11
    s_mov_b32 s31, 1
    s_and_b32 s27, s27, 0xff
    s_cmp_lg_u32 s27, 4
    s_cbranch_scc1 L_exit
L_try:
    global_load_dwordx4 v[12:15], v3, s[14:15] sc1
    global_load_dwordx2 v[16:17], v57, s[14:15] offset:512 sc1
    global_load_dwordx4 v[20:23], v4, s[14:15] sc1
    global_load_dwordx2 v[24:25], v58, s[14:15] offset:512 sc1
    global_load_dwordx4 v[28:31], v5, s[14:15] sc1
    global_load_dwordx2 v[32:33], v59, s[14:15] offset:512 sc1
    s_waitcnt vmcnt(0)
    v_max3_u32 v60, v12, v13, v14
    v_max3_u32 v61, v20, v21, v22
    v_max3_u32 v62, v28, v29, v30
    v_max3_u32 v60, v60, v15, v16
    v_max3_u32 v61, v61, v23, v24
    v_max3_u32 v62, v62, v31, v32
    v_max3_u32 v60, v60, v17, v25
    v_max3_u32 v61, v61, v62, v33
    v_max_u32 v60, v60, v61
    v_cmp_eq_u32 vcc, -1, v60
    s_cbranch_vccnz L_try_fail
L_scale:
    v_max3_f32 v60, v40, v16, v24
    v_max_f32 v60, v60, v32
    v_sub_f32 v52, v40, v60
    v_sub_f32 v61, v16, v60
    v_sub_f32 v62, v24, v60
    v_sub_f32 v63, v32, v60
    v_exp_f32 v52, v52
    v_exp_f32 v61, v61
    v_exp_f32 v62, v62
    v_exp_f32 v63, v63
    s_nop 0
    v_pk_mul_f32 v[44:45], v[12:13], v[60:61] op_sel:[0,1] op_sel_hi:[1,1]
    v_pk_mul_f32 v[46:47], v[14:15], v[60:61] op_sel:[0,1] op_sel_hi:[1,1]
    v_pk_mul_f32 v[48:49], v[20:21], v[62:63] op_sel:[0,0] op_sel_hi:[1,0]
    v_pk_mul_f32 v[50:51], v[22:23], v[62:63] op_sel:[0,0] op_sel_hi:[1,0]
    v_pk_mul_f32 v[28:29], v[28:29], v[62:63] op_sel:[0,1] op_sel_hi:[1,1]
    v_pk_mul_f32 v[30:31], v[30:31], v[62:63] op_sel:[0,1] op_sel_hi:[1,1]
    v_mul_f32 v53, v61, v17
    v_mul_f32 v54, v62, v25
    v_mul_f32 v63, v63, v33
    v_pk_add_f32 v[48:49], v[48:49], v[28:29]
    v_pk_add_f32 v[50:51], v[50:51], v[30:31]
    v_add_f32 v54, v54, v63
L_final:
    v_mul_f32 v65, v52, v41
    v_pk_mul_f32 v[36:37], v[36:37], v[52:53] op_sel:[0,0] op_sel_hi:[1,0]
    v_pk_mul_f32 v[38:39], v[38:39], v[52:53] op_sel:[0,0] op_sel_hi:[1,0]
    v_add_f32 v65, v65, v53
    v_pk_add_f32 v[36:37], v[36:37], v[44:45]
    v_pk_add_f32 v[38:39], v[38:39], v[46:47]
    v_add_f32 v65, v65, v54
    v_pk_add_f32 v[36:37], v[36:37], v[48:49]
    v_pk_add_f32 v[38:39], v[38:39], v[50:51]
    v_rcp_f32 v64, v65
    s_nop 0
    v_pk_mul_f32 v[36:37], v[36:37], v[64:65] op_sel:[0,0] op_sel_hi:[1,0]
    v_pk_mul_f32 v[38:39], v[38:39], v[64:65] op_sel:[0,0] op_sel_hi:[1,0]
    v_cvt_pk_bf16_f32 v56, v36, v37
    v_cvt_pk_bf16_f32 v57, v38, v39
    global_store_dwordx2 v6, v[56:57], s[10:11]
    s_endpgm
L_try_fail:
    s_sub_u32 s31, s31, 1
    s_cmp_lg_u32 s31, 0
    s_cbranch_scc1 L_try
L_exit:
L_end:
    s_endpgm
.section .rodata,"a"
.p2align 6
.amdhsa_kernel standalone__gqa_softmax__decode_kernel
  .amdhsa_next_free_vgpr 256
  .amdhsa_next_free_sgpr 64
  .amdhsa_accum_offset 256
  .amdhsa_group_segment_fixed_size 0
  .amdhsa_kernarg_size 48
  .amdhsa_user_sgpr_count 2
  .amdhsa_user_sgpr_kernarg_segment_ptr 1
  .amdhsa_system_sgpr_workgroup_id_x 1
  .amdhsa_float_denorm_mode_32 3
.end_amdhsa_kernel
```
